```python
import torch

def _softmax(x, axis=-1):
    return torch.softmax(x, dim=axis)
def _gelu(x):
    return torch.nn.functional.gelu(x, approximate="tanh")
def _silu(x):
    return torch.nn.functional.silu(x)
def _sigmoid(x):
    return torch.sigmoid(x)
def _layernorm(x, axis=-1, eps=1e-5):
    m = x.mean(dim=axis, keepdim=True)
    v = x.var(dim=axis, keepdim=True, unbiased=False)
    return (x - m) / torch.sqrt(v + eps)
def _scatter_add(tgt, idx, src, axis=0):
    return tgt.clone().index_add_(axis, idx, src)
def _segment_sum(src, seg, n):
    out = torch.zeros((n,) + src.shape[1:], dtype=src.dtype)
    return out.index_add_(0, seg, src)
def _pad(x, pw):
    flat = tuple(v for pair in reversed(pw) for v in pair)
    return torch.nn.functional.pad(x, flat)

kernel_name = 'standalone__self_sup_conv_stem_hubert__speech'

def setup_inputs():

    _w = (lambda a: (lambda t: t.to(torch.bfloat16) if t.is_floating_point() else t)(torch.as_tensor(a)))
    B, T, D, K = 2, 4000, 512, 15
    scale = (1.0 / (K * D)) ** 0.5
    return {
        "x": _w((lambda *s: torch.randn(*s, dtype=torch.bfloat16) * 0.05)(B, T, D)),
        "w": _w((lambda *s: torch.randn(*s, dtype=torch.bfloat16) * 0.05)(K, D, D) * scale),
        "b": _w((lambda *s: torch.randn(*s, dtype=torch.bfloat16) * 0.05)(D) * 0.1),
        "gamma": _w(torch.ones((D,), dtype=float)),
        "beta": _w(torch.zeros((D,), dtype=float)),
    }

def reference(x, w, b, gamma, beta):
    B, T, D = x.shape
    K = w.shape[0]
    s = 2
    L = (T - K) // s + 1
    y = torch.einsum('blc,cd->bld', x[:, 0 : s * L : s, :], w[0])
    for i in range(1, K):
        y = y + torch.einsum('blc,cd->bld', x[:, i : i + s * L : s, :], w[i])
    y = y + b[None, None, :]
    mu = y.mean(1, keepdims=True)
    var = ((y - mu) ** 2).mean(1, keepdims=True)
    yn = (y - mu) / torch.sqrt(var + 1e-5)
    yn = yn * gamma[None, None, :] + beta[None, None, :]
    return _gelu(yn)
```

```asm
; @launch grid=(256,1,1) block=(576,1,1) lds=152640
.amdgcn_target "amdgcn-amd-amdhsa--gfx950"
.text
.globl standalone__self_sup_conv_stem_hubert__speech_kernel
.p2align 8
.type standalone__self_sup_conv_stem_hubert__speech_kernel,@function
standalone__self_sup_conv_stem_hubert__speech_kernel:
    s_cmp_ge_u32 s2, 256
    s_cbranch_scc1 L_end
    s_load_dwordx16 s[4:19], s[0:1], 0
    v_lshrrev_b32 v2, 6, v0
    v_and_b32 v1, 63, v0
    v_readfirstlane_b32 s49, v2
    s_and_b32 s44, s2, 7
    s_lshr_b32 s45, s2, 3
    s_lshr_b32 s46, s44, 2
    s_and_b32 s47, s44, 3
    s_lshl_b32 s47, s47, 1
    s_lshr_b32 s57, s45, 4
    s_add_u32 s47, s47, s57
    s_and_b32 s48, s45, 15
    s_and_b32 s88, s49, 7
    v_lshrrev_b32 v2, 3, v1
    v_and_b32 v3, 7, v1
    v_lshlrev_b32 v4, 10, v2
    v_lshl_add_u32 v4, v3, 4, v4
    s_lshl_b32 s57, s88, 13
    v_add_u32 v9, s57, v4
    s_and_b32 s58, s88, 1
    s_add_u32 s59, s58, 32
    s_lshl_b32 s60, s59, 13
    v_add_u32 v11, s60, v4
    s_mul_i32 s54, s59, 1040
    s_mul_i32 s53, s88, 1040
    v_bfe_u32 v4, v1, 4, 1
    s_lshl_b32 s58, s58, 1
    v_or_b32 v4, s58, v4
    v_lshlrev_b32 v4, 1, v4
    v_xor_b32 v4, v4, v3
    v_lshlrev_b32 v8, 10, v2
    v_lshl_add_u32 v8, v4, 4, v8
    s_lshl_b32 s58, s47, 7
    s_add_u32 s58, s58, s57
    v_add_u32 v8, s58, v8
    s_lshl_b32 s52, s88, 10
    s_add_u32 s52, s52, 70720
    s_and_b32 s55, s44, 3
    s_lshl_b32 s55, s55, 1
    s_add_u32 s57, s55, 0
    s_and_b32 s57, s57, 7
    s_lshl_b32 s61, s57, 16
    s_lshl_b32 s65, s57, 7
    s_add_u32 s57, s55, 1
    s_and_b32 s57, s57, 7
    s_lshl_b32 s62, s57, 16
    s_lshl_b32 s66, s57, 7
    s_add_u32 s57, s55, 2
    s_and_b32 s57, s57, 7
    s_lshl_b32 s63, s57, 16
    s_lshl_b32 s67, s57, 7
    s_add_u32 s57, s55, 3
    s_and_b32 s57, s57, 7
    s_lshl_b32 s64, s57, 16
    s_lshl_b32 s68, s57, 7
    s_mul_i32 s57, s46, 4096000
    s_lshl_b32 s58, s48, 18
    s_add_u32 s59, s57, s58
    s_waitcnt lgkmcnt(0)
    s_add_u32 s20, s4, s59
    s_addc_u32 s21, s5, 0
    s_and_b32 s21, s21, 0xffff
    s_sub_u32 s22, 4096000, s58
    s_mov_b32 s23, 0x00020000
    s_mov_b32 s24, s6
    s_and_b32 s25, s7, 0xffff
    s_mov_b32 s26, 7864320
    s_mov_b32 s27, 0x00020000
    s_cmp_eq_u32 s49, 8
    s_cbranch_scc1 L_helper
    s_add_u32 m0, s53, 0
    s_add_u32 s58, s65, 0
    buffer_load_dwordx4 v9, s[20:23], s58 offen lds
    s_add_u32 m0, s53, 8320
    s_add_u32 s58, s65, 65536
    buffer_load_dwordx4 v9, s[20:23], s58 offen lds
    s_add_u32 m0, s53, 16640
    s_add_u32 s58, s65, 131072
    buffer_load_dwordx4 v9, s[20:23], s58 offen lds
    s_add_u32 m0, s53, 24960
    s_add_u32 s58, s65, 196608
    buffer_load_dwordx4 v9, s[20:23], s58 offen lds
    s_add_u32 m0, s54, 0
    s_mov_b32 s58, s65
    buffer_load_dwordx4 v11, s[20:23], s58 offen lds
    s_add_u32 m0, s52, 0
    s_add_u32 s57, s61, 0
    buffer_load_dwordx4 v8, s[24:27], s57 offen lds
    s_add_u32 m0, s52, 8192
    s_add_u32 s57, s61, 1048576
    buffer_load_dwordx4 v8, s[24:27], s57 offen lds
    s_add_u32 m0, s52, 16384
    s_add_u32 s57, s61, 2097152
    buffer_load_dwordx4 v8, s[24:27], s57 offen lds
    s_add_u32 m0, s52, 24576
    s_add_u32 s57, s61, 3145728
    buffer_load_dwordx4 v8, s[24:27], s57 offen lds
    s_lshr_b32 s50, s49, 2
    s_and_b32 s51, s49, 3
    s_lshl_b32 s71, s46, 3
    s_add_u32 s71, s71, s47
    s_mov_b32 s56, 0
    v_and_b32 v2, 15, v1
    v_lshrrev_b32 v3, 4, v1
    s_mov_b32 s32, s8
    s_and_b32 s33, s9, 0xffff
    s_mov_b32 s34, 1024
    s_mov_b32 s35, 0x00020000
    s_lshl_b32 s57, s47, 7
    s_lshl_b32 s58, s51, 5
    s_add_u32 s58, s57, s58
    v_lshl_add_u32 v4, v2, 1, s58
    buffer_load_ushort v10, v4, s[32:35], 0 offen
    v_lshl_add_u32 v4, v1, 1, s57
    s_mov_b32 s32, s10
    s_and_b32 s33, s11, 0xffff
    s_mov_b32 s34, 1024
    s_mov_b32 s35, 0x00020000
    buffer_load_ushort v0, v4, s[32:35], 0 offen
    s_mov_b32 s32, s12
    s_and_b32 s33, s13, 0xffff
    s_mov_b32 s34, 1024
    s_mov_b32 s35, 0x00020000
    v_mov_b32 v120, v4
    s_mov_b32 s28, s18
    s_and_b32 s29, s19, 0xffff
    s_mov_b32 s30, 268435456
    s_mov_b32 s31, 0x00020000
    s_mov_b32 s36, s14
    s_and_b32 s37, s15, 0xffff
    s_mov_b32 s38, 4081664
    s_mov_b32 s39, 0x00020000
    s_mov_b32 s40, s16
    s_and_b32 s41, s17, 0xffff
    s_mov_b32 s42, 256
    s_mov_b32 s43, 0x00020000
    v_mul_u32_u24 v6, 2080, v2
    s_lshl_b32 s57, s50, 2
    v_add_u32 v4, s57, v3
    v_lshl_add_u32 v6, v4, 4, v6
    v_bfe_u32 v4, v1, 2, 2
    v_lshl_add_u32 v7, v3, 3, v4
    v_lshlrev_b32 v7, 7, v7
    v_bfe_u32 v4, v1, 3, 2
    v_xor_b32 v4, s51, v4
    v_lshl_add_u32 v7, v4, 5, v7
    v_and_b32 v4, 3, v1
    v_lshl_add_u32 v7, v4, 3, v7
    s_lshl_b32 s58, s50, 12
    s_add_u32 s58, s58, 70720
    v_add_u32 v7, s58, v7
    v_add_u32 v5, 40960, v7
    s_movk_i32 s69, 128
    s_sub_u32 s58, 37, s50
    s_cmp_eq_u32 s48, 15
    s_cselect_b32 s69, 73, s69
    s_cselect_b32 s70, s58, 64
    v_lshl_add_u32 v4, v3, 5, s57
    s_sub_i32 s58, s69, 0
    v_cmp_gt_i32 s[4:5], s58, v4
    s_sub_i32 s58, s69, 8
    v_cmp_gt_i32 s[6:7], s58, v4
    s_sub_i32 s58, s69, 16
    v_cmp_gt_i32 s[8:9], s58, v4
    s_sub_i32 s58, s69, 24
    v_cmp_gt_i32 s[10:11], s58, v4
    s_sub_i32 s58, s69, 1
    v_cmp_gt_i32 s[12:13], s58, v4
    s_sub_i32 s58, s69, 9
    v_cmp_gt_i32 s[14:15], s58, v4
    s_sub_i32 s58, s69, 17
    v_cmp_gt_i32 s[16:17], s58, v4
    s_sub_i32 s58, s69, 25
    v_cmp_gt_i32 s[18:19], s58, v4
    s_sub_i32 s58, s69, 2
    v_cmp_gt_i32 s[72:73], s58, v4
    s_sub_i32 s58, s69, 10
    v_cmp_gt_i32 s[74:75], s58, v4
    s_sub_i32 s58, s69, 18
    v_cmp_gt_i32 s[76:77], s58, v4
    s_sub_i32 s58, s69, 26
    v_cmp_gt_i32 s[78:79], s58, v4
    s_sub_i32 s58, s69, 3
    v_cmp_gt_i32 s[80:81], s58, v4
    s_sub_i32 s58, s69, 11
    v_cmp_gt_i32 s[82:83], s58, v4
    s_sub_i32 s58, s69, 19
    v_cmp_gt_i32 s[84:85], s58, v4
    s_sub_i32 s58, s69, 27
    v_cmp_gt_i32 s[86:87], s58, v4
    s_lshl_b32 s57, s51, 13
    s_lshl_b32 s58, s50, 12
    s_add_u32 s59, s57, s58
    s_add_u32 s59, s59, 2048
    s_xor_b32 s60, s59, 4096
    v_lshl_add_u32 v2, v1, 4, s60
    v_lshl_add_u32 v3, v1, 4, s59
    buffer_load_ushort v1, v120, s[32:35], 0 offen
    v_mov_b32 v136, 0
    v_mov_b32 v137, 0
    v_mov_b32 v138, 0
    v_mov_b32 v139, 0
    v_mov_b32 v140, 0
    v_mov_b32 v141, 0
    v_mov_b32 v142, 0
    v_mov_b32 v143, 0
    v_mov_b32 v144, 0
    v_mov_b32 v145, 0
    v_mov_b32 v146, 0
    v_mov_b32 v147, 0
    v_mov_b32 v148, 0
    v_mov_b32 v149, 0
    v_mov_b32 v150, 0
    v_mov_b32 v151, 0
    v_mov_b32 v152, 0
    v_mov_b32 v153, 0
    v_mov_b32 v154, 0
    v_mov_b32 v155, 0
    v_mov_b32 v156, 0
    v_mov_b32 v157, 0
    v_mov_b32 v158, 0
    v_mov_b32 v159, 0
    v_mov_b32 v160, 0
    v_mov_b32 v161, 0
    v_mov_b32 v162, 0
    v_mov_b32 v163, 0
    v_mov_b32 v164, 0
    v_mov_b32 v165, 0
    v_mov_b32 v166, 0
    v_mov_b32 v167, 0
    s_waitcnt vmcnt(3)
    s_barrier
    ds_read_b64_tr_b16 v[120:121], v7 offset:0
    ds_read_b64_tr_b16 v[122:123], v7 offset:512
    ds_read_b64_tr_b16 v[124:125], v7 offset:8192
    ds_read_b64_tr_b16 v[126:127], v7 offset:8704
    ds_read_b128 v[12:15], v6 offset:0
    ds_read_b128 v[16:19], v6 offset:256
    ds_read_b128 v[20:23], v6 offset:512
    ds_read_b128 v[24:27], v6 offset:768
    ds_read_b128 v[28:31], v6 offset:1040
    ds_read_b128 v[32:35], v6 offset:1296
    ds_read_b128 v[36:39], v6 offset:1552
    ds_read_b128 v[40:43], v6 offset:1808
    ds_read_b128 v[44:47], v6 offset:2080
L_loop0:
    s_waitcnt vmcnt(9) lgkmcnt(0)
    v_mfma_f32_16x16x32_bf16 v[136:139], v[12:15], v[120:123], v[136:139]
    ds_read_b64_tr_b16 v[128:129], v7 offset:16384
    v_mfma_f32_16x16x32_bf16 v[136:139], v[16:19], v[124:127], v[136:139]
    s_barrier
    ds_read_b64_tr_b16 v[130:131], v7 offset:16896
    v_mfma_f32_16x16x32_bf16 v[140:143], v[16:19], v[120:123], v[140:143]
    s_add_u32 m0, s52, 0
    v_mfma_f32_16x16x32_bf16 v[140:143], v[20:23], v[124:127], v[140:143]
    ds_read_b64_tr_b16 v[132:133], v7 offset:24576
    v_mfma_f32_16x16x32_bf16 v[144:147], v[20:23], v[120:123], v[144:147]
    s_add_u32 s57, s61, 2621440
    v_mfma_f32_16x16x32_bf16 v[144:147], v[24:27], v[124:127], v[144:147]
    ds_read_b64_tr_b16 v[134:135], v7 offset:25088
    v_mfma_f32_16x16x32_bf16 v[148:151], v[24:27], v[120:123], v[148:151]
    buffer_load_dwordx4 v8, s[24:27], s57 offen lds
    v_mfma_f32_16x16x32_bf16 v[148:151], v[28:31], v[124:127], v[148:151]
    ds_read_b128 v[48:51], v6 offset:2336
    v_mfma_f32_16x16x32_bf16 v[152:155], v[28:31], v[120:123], v[152:155]
    ds_read_b128 v[52:55], v6 offset:2592
    s_add_u32 m0, s52, 8192
    v_mfma_f32_16x16x32_bf16 v[152:155], v[32:35], v[124:127], v[152:155]
    v_mfma_f32_16x16x32_bf16 v[156:159], v[32:35], v[120:123], v[156:159]
    ds_read_b128 v[56:59], v6 offset:2848
    s_add_u32 s57, s61, 3670016
    v_mfma_f32_16x16x32_bf16 v[156:159], v[36:39], v[124:127], v[156:159]
    v_mfma_f32_16x16x32_bf16 v[160:163], v[36:39], v[120:123], v[160:163]
    ds_read_b128 v[60:63], v6 offset:3120
    buffer_load_dwordx4 v8, s[24:27], s57 offen lds
    v_mfma_f32_16x16x32_bf16 v[160:163], v[40:43], v[124:127], v[160:163]
    v_mfma_f32_16x16x32_bf16 v[164:167], v[40:43], v[120:123], v[164:167]
    v_mfma_f32_16x16x32_bf16 v[164:167], v[44:47], v[124:127], v[164:167]
    s_waitcnt vmcnt(7) lgkmcnt(0)
    v_mfma_f32_16x16x32_bf16 v[136:139], v[20:23], v[128:131], v[136:139]
    ds_read_b64_tr_b16 v[120:121], v7 offset:32768
    v_mfma_f32_16x16x32_bf16 v[136:139], v[24:27], v[132:135], v[136:139]
    s_barrier
    ds_read_b64_tr_b16 v[122:123], v7 offset:33280
    v_mfma_f32_16x16x32_bf16 v[140:143], v[24:27], v[128:131], v[140:143]
    s_add_u32 m0, s52, 16384
    v_mfma_f32_16x16x32_bf16 v[140:143], v[28:31], v[132:135], v[140:143]
    ds_read_b64_tr_b16 v[124:125], v5 offset:0
    v_mfma_f32_16x16x32_bf16 v[144:147], v[28:31], v[128:131], v[144:147]
    s_add_u32 s57, s61, 4718592
    v_mfma_f32_16x16x32_bf16 v[144:147], v[32:35], v[132:135], v[144:147]
    ds_read_b64_tr_b16 v[126:127], v5 offset:512
    v_mfma_f32_16x16x32_bf16 v[148:151], v[32:35], v[128:131], v[148:151]
    buffer_load_dwordx4 v8, s[24:27], s57 offen lds
    v_mfma_f32_16x16x32_bf16 v[148:151], v[36:39], v[132:135], v[148:151]
    ds_read_b128 v[64:67], v6 offset:3376
    v_mfma_f32_16x16x32_bf16 v[152:155], v[36:39], v[128:131], v[152:155]
    ds_read_b128 v[68:71], v6 offset:3632
    s_add_u32 m0, s52, 24576
    v_mfma_f32_16x16x32_bf16 v[152:155], v[40:43], v[132:135], v[152:155]
    v_mfma_f32_16x16x32_bf16 v[156:159], v[40:43], v[128:131], v[156:159]
    ds_read_b128 v[72:75], v6 offset:640
    s_add_u32 s57, s61, 5767168
    v_mfma_f32_16x16x32_bf16 v[156:159], v[44:47], v[132:135], v[156:159]
    v_mfma_f32_16x16x32_bf16 v[160:163], v[44:47], v[128:131], v[160:163]
    ds_read_b128 v[76:79], v6 offset:896
    buffer_load_dwordx4 v8, s[24:27], s57 offen lds
    v_mfma_f32_16x16x32_bf16 v[160:163], v[48:51], v[132:135], v[160:163]
    v_mfma_f32_16x16x32_bf16 v[164:167], v[48:51], v[128:131], v[164:167]
    v_mfma_f32_16x16x32_bf16 v[164:167], v[52:55], v[132:135], v[164:167]
    s_waitcnt vmcnt(5) lgkmcnt(0)
    v_mfma_f32_16x16x32_bf16 v[136:139], v[28:31], v[120:123], v[136:139]
    ds_read_b64_tr_b16 v[128:129], v5 offset:8192
    v_mfma_f32_16x16x32_bf16 v[136:139], v[32:35], v[124:127], v[136:139]
    s_barrier
    ds_read_b64_tr_b16 v[130:131], v5 offset:8704
    v_mfma_f32_16x16x32_bf16 v[140:143], v[32:35], v[120:123], v[140:143]
    s_add_u32 m0, s52, 32768
    v_mfma_f32_16x16x32_bf16 v[140:143], v[36:39], v[124:127], v[140:143]
    ds_read_b64_tr_b16 v[132:133], v5 offset:16384
    v_mfma_f32_16x16x32_bf16 v[144:147], v[36:39], v[120:123], v[144:147]
    s_add_u32 s57, s61, 6815744
    v_mfma_f32_16x16x32_bf16 v[144:147], v[40:43], v[124:127], v[144:147]
    ds_read_b64_tr_b16 v[134:135], v5 offset:16896
    v_mfma_f32_16x16x32_bf16 v[148:151], v[40:43], v[120:123], v[148:151]
    buffer_load_dwordx4 v8, s[24:27], s57 offen lds
    v_mfma_f32_16x16x32_bf16 v[148:151], v[44:47], v[124:127], v[148:151]
    ds_read_b128 v[12:15], v6 offset:128
    v_mfma_f32_16x16x32_bf16 v[152:155], v[44:47], v[120:123], v[152:155]
    ds_read_b128 v[16:19], v6 offset:384
    s_add_u32 m0, s52, 40960
    v_mfma_f32_16x16x32_bf16 v[152:155], v[48:51], v[124:127], v[152:155]
    v_mfma_f32_16x16x32_bf16 v[156:159], v[48:51], v[120:123], v[156:159]
    ds_read_b128 v[80:83], v6 offset:1168
    s_add_u32 s57, s62, 0
    v_mfma_f32_16x16x32_bf16 v[156:159], v[52:55], v[124:127], v[156:159]
    v_mfma_f32_16x16x32_bf16 v[160:163], v[52:55], v[120:123], v[160:163]
    ds_read_b128 v[84:87], v6 offset:1424
    buffer_load_dwordx4 v8, s[24:27], s57 offen lds
    v_mfma_f32_16x16x32_bf16 v[160:163], v[56:59], v[124:127], v[160:163]
    v_mfma_f32_16x16x32_bf16 v[164:167], v[56:59], v[120:123], v[164:167]
    v_mfma_f32_16x16x32_bf16 v[164:167], v[60:63], v[124:127], v[164:167]
    s_waitcnt vmcnt(4) lgkmcnt(0)
    v_mfma_f32_16x16x32_bf16 v[136:139], v[36:39], v[128:131], v[136:139]
    ds_read_b64_tr_b16 v[120:121], v5 offset:24576
    v_mfma_f32_16x16x32_bf16 v[136:139], v[40:43], v[132:135], v[136:139]
    s_barrier
    ds_read_b64_tr_b16 v[122:123], v5 offset:25088
    v_mfma_f32_16x16x32_bf16 v[140:143], v[40:43], v[128:131], v[140:143]
    s_add_u32 m0, s52, 49152
    v_mfma_f32_16x16x32_bf16 v[140:143], v[44:47], v[132:135], v[140:143]
    ds_read_b64_tr_b16 v[124:125], v5 offset:32768
    v_mfma_f32_16x16x32_bf16 v[144:147], v[44:47], v[128:131], v[144:147]
    s_add_u32 s57, s62, 1048576
    v_mfma_f32_16x16x32_bf16 v[144:147], v[48:51], v[132:135], v[144:147]
    ds_read_b64_tr_b16 v[126:127], v5 offset:33280
    v_mfma_f32_16x16x32_bf16 v[148:151], v[48:51], v[128:131], v[148:151]
    buffer_load_dwordx4 v8, s[24:27], s57 offen lds
    v_mfma_f32_16x16x32_bf16 v[148:151], v[52:55], v[132:135], v[148:151]
    ds_read_b128 v[88:91], v6 offset:1680
    v_mfma_f32_16x16x32_bf16 v[152:155], v[52:55], v[128:131], v[152:155]
    ds_read_b128 v[92:95], v6 offset:1936
    s_add_u32 m0, s52, 57344
    v_mfma_f32_16x16x32_bf16 v[152:155], v[56:59], v[132:135], v[152:155]
    v_mfma_f32_16x16x32_bf16 v[156:159], v[56:59], v[128:131], v[156:159]
    ds_read_b128 v[96:99], v6 offset:2208
    s_add_u32 s57, s62, 2097152
    v_mfma_f32_16x16x32_bf16 v[156:159], v[60:63], v[132:135], v[156:159]
    v_mfma_f32_16x16x32_bf16 v[160:163], v[60:63], v[128:131], v[160:163]
    ds_read_b128 v[100:103], v6 offset:2464
    buffer_load_dwordx4 v8, s[24:27], s57 offen lds
    v_mfma_f32_16x16x32_bf16 v[160:163], v[64:67], v[132:135], v[160:163]
    v_mfma_f32_16x16x32_bf16 v[164:167], v[64:67], v[128:131], v[164:167]
    v_mfma_f32_16x16x32_bf16 v[164:167], v[68:71], v[132:135], v[164:167]
    s_waitcnt vmcnt(4) lgkmcnt(0)
    v_mfma_f32_16x16x32_bf16 v[136:139], v[12:15], v[120:123], v[136:139]
    ds_read_b64_tr_b16 v[128:129], v7 offset:0
    v_mfma_f32_16x16x32_bf16 v[136:139], v[16:19], v[124:127], v[136:139]
    s_barrier
    ds_read_b64_tr_b16 v[130:131], v7 offset:512
    v_mfma_f32_16x16x32_bf16 v[140:143], v[16:19], v[120:123], v[140:143]
    s_add_u32 m0, s52, 65536
    v_mfma_f32_16x16x32_bf16 v[140:143], v[72:75], v[124:127], v[140:143]
    ds_read_b64_tr_b16 v[132:133], v7 offset:8192
    v_mfma_f32_16x16x32_bf16 v[144:147], v[72:75], v[120:123], v[144:147]
    s_add_u32 s57, s62, 3145728
    v_mfma_f32_16x16x32_bf16 v[144:147], v[76:79], v[124:127], v[144:147]
    ds_read_b64_tr_b16 v[134:135], v7 offset:8704
    v_mfma_f32_16x16x32_bf16 v[148:151], v[76:79], v[120:123], v[148:151]
    buffer_load_dwordx4 v8, s[24:27], s57 offen lds
    v_mfma_f32_16x16x32_bf16 v[148:151], v[80:83], v[124:127], v[148:151]
    ds_read_b128 v[104:107], v6 offset:2720
    v_mfma_f32_16x16x32_bf16 v[152:155], v[80:83], v[120:123], v[152:155]
    ds_read_b128 v[108:111], v6 offset:2976
    s_add_u32 m0, s52, 73728
    v_mfma_f32_16x16x32_bf16 v[152:155], v[84:87], v[124:127], v[152:155]
    v_mfma_f32_16x16x32_bf16 v[156:159], v[84:87], v[120:123], v[156:159]
    ds_read_b128 v[112:115], v6 offset:3248
    s_add_u32 s57, s62, 4194304
    v_mfma_f32_16x16x32_bf16 v[156:159], v[88:91], v[124:127], v[156:159]
    v_mfma_f32_16x16x32_bf16 v[160:163], v[88:91], v[120:123], v[160:163]
    ds_read_b128 v[116:119], v6 offset:3504
    buffer_load_dwordx4 v8, s[24:27], s57 offen lds
    v_mfma_f32_16x16x32_bf16 v[160:163], v[92:95], v[124:127], v[160:163]
    v_mfma_f32_16x16x32_bf16 v[164:167], v[92:95], v[120:123], v[164:167]
    v_mfma_f32_16x16x32_bf16 v[164:167], v[96:99], v[124:127], v[164:167]
    s_waitcnt vmcnt(5) lgkmcnt(0)
    v_mfma_f32_16x16x32_bf16 v[136:139], v[72:75], v[128:131], v[136:139]
    ds_read_b64_tr_b16 v[120:121], v7 offset:16384
    v_mfma_f32_16x16x32_bf16 v[136:139], v[76:79], v[132:135], v[136:139]
    s_barrier
    ds_read_b64_tr_b16 v[122:123], v7 offset:16896
    s_add_u32 m0, s52, 0
    v_mfma_f32_16x16x32_bf16 v[140:143], v[76:79], v[128:131], v[140:143]
    s_add_u32 s57, s62, 5242880
    v_mfma_f32_16x16x32_bf16 v[140:143], v[80:83], v[132:135], v[140:143]
    ds_read_b64_tr_b16 v[124:125], v7 offset:24576
    buffer_load_dwordx4 v8, s[24:27], s57 offen lds
    v_mfma_f32_16x16x32_bf16 v[144:147], v[80:83], v[128:131], v[144:147]
    s_cmp_eq_u32 s56, 3
    s_cselect_b32 s22, 0, s22
    v_mfma_f32_16x16x32_bf16 v[144:147], v[84:87], v[132:135], v[144:147]
    ds_read_b64_tr_b16 v[126:127], v7 offset:25088
    s_add_u32 m0, s53, 0
    v_mfma_f32_16x16x32_bf16 v[148:151], v[84:87], v[128:131], v[148:151]
    s_add_u32 s58, s67, 0
    v_mfma_f32_16x16x32_bf16 v[148:151], v[88:91], v[132:135], v[148:151]
    ds_read_b128 v[12:15], v6 offset:35360
    buffer_load_dwordx4 v9, s[20:23], s58 offen lds
    v_mfma_f32_16x16x32_bf16 v[152:155], v[88:91], v[128:131], v[152:155]
    ds_read_b128 v[16:19], v6 offset:35616
    s_add_u32 m0, s52, 8192
    v_mfma_f32_16x16x32_bf16 v[152:155], v[92:95], v[132:135], v[152:155]
    s_add_u32 s57, s62, 6291456
    v_mfma_f32_16x16x32_bf16 v[156:159], v[92:95], v[128:131], v[156:159]
    ds_read_b128 v[20:23], v6 offset:35872
    buffer_load_dwordx4 v8, s[24:27], s57 offen lds
    v_mfma_f32_16x16x32_bf16 v[156:159], v[96:99], v[132:135], v[156:159]
    s_add_u32 m0, s53, 8320
    v_mfma_f32_16x16x32_bf16 v[160:163], v[96:99], v[128:131], v[160:163]
    ds_read_b128 v[24:27], v6 offset:36128
    s_add_u32 s58, s67, 65536
    v_mfma_f32_16x16x32_bf16 v[160:163], v[100:103], v[132:135], v[160:163]
    buffer_load_dwordx4 v9, s[20:23], s58 offen lds
    v_mfma_f32_16x16x32_bf16 v[164:167], v[100:103], v[128:131], v[164:167]
    v_mfma_f32_16x16x32_bf16 v[164:167], v[104:107], v[132:135], v[164:167]
    s_waitcnt vmcnt(7) lgkmcnt(0)
    v_mfma_f32_16x16x32_bf16 v[136:139], v[80:83], v[120:123], v[136:139]
    ds_read_b64_tr_b16 v[128:129], v7 offset:32768
    v_mfma_f32_16x16x32_bf16 v[136:139], v[84:87], v[124:127], v[136:139]
    s_barrier
    s_add_u32 m0, s52, 16384
    v_mfma_f32_16x16x32_bf16 v[140:143], v[84:87], v[120:123], v[140:143]
    ds_read_b64_tr_b16 v[130:131], v7 offset:33280
    s_add_u32 s57, s62, 7340032
    v_mfma_f32_16x16x32_bf16 v[140:143], v[88:91], v[124:127], v[140:143]
    buffer_load_dwordx4 v8, s[24:27], s57 offen lds
    v_mfma_f32_16x16x32_bf16 v[144:147], v[88:91], v[120:123], v[144:147]
    ds_read_b128 v[28:31], v6 offset:36400
    s_add_u32 m0, s53, 16640
    v_mfma_f32_16x16x32_bf16 v[144:147], v[92:95], v[124:127], v[144:147]
    s_add_u32 s58, s67, 131072
    v_mfma_f32_16x16x32_bf16 v[148:151], v[92:95], v[120:123], v[148:151]
    buffer_load_dwordx4 v9, s[20:23], s58 offen lds
    v_mfma_f32_16x16x32_bf16 v[148:151], v[96:99], v[124:127], v[148:151]
    ds_read_b128 v[32:35], v6 offset:36656
    v_mfma_f32_16x16x32_bf16 v[152:155], v[96:99], v[120:123], v[152:155]
    s_add_u32 m0, s52, 24576
    v_mfma_f32_16x16x32_bf16 v[152:155], v[100:103], v[124:127], v[152:155]
    ds_read_b128 v[36:39], v6 offset:36912
    s_add_u32 s57, s62, 524288
    v_mfma_f32_16x16x32_bf16 v[156:159], v[100:103], v[120:123], v[156:159]
    buffer_load_dwordx4 v8, s[24:27], s57 offen lds
    v_mfma_f32_16x16x32_bf16 v[156:159], v[104:107], v[124:127], v[156:159]
    ds_read_b128 v[40:43], v6 offset:37168
    s_add_u32 m0, s53, 24960
    v_mfma_f32_16x16x32_bf16 v[160:163], v[104:107], v[120:123], v[160:163]
    s_add_u32 s58, s67, 196608
    v_mfma_f32_16x16x32_bf16 v[160:163], v[108:111], v[124:127], v[160:163]
    buffer_load_dwordx4 v9, s[20:23], s58 offen lds
    v_mfma_f32_16x16x32_bf16 v[164:167], v[108:111], v[120:123], v[164:167]
    v_mfma_f32_16x16x32_bf16 v[164:167], v[112:115], v[124:127], v[164:167]
    s_waitcnt vmcnt(9) lgkmcnt(0)
    v_mfma_f32_16x16x32_bf16 v[136:139], v[88:91], v[128:131], v[136:139]
    ds_read_b64_tr_b16 v[120:121], v5 offset:0
    v_mfma_f32_16x16x32_bf16 v[140:143], v[92:95], v[128:131], v[140:143]
    s_barrier
    ds_read_b64_tr_b16 v[122:123], v5 offset:512
    s_add_u32 m0, s52, 32768
    v_mfma_f32_16x16x32_bf16 v[144:147], v[96:99], v[128:131], v[144:147]
    ds_read_b64_tr_b16 v[124:125], v5 offset:8192
    s_add_u32 s57, s62, 1572864
    v_mfma_f32_16x16x32_bf16 v[148:151], v[100:103], v[128:131], v[148:151]
    ds_read_b64_tr_b16 v[126:127], v5 offset:8704
    buffer_load_dwordx4 v8, s[24:27], s57 offen lds
    s_add_u32 m0, s54, 0
    v_mfma_f32_16x16x32_bf16 v[152:155], v[104:107], v[128:131], v[152:155]
    ds_read_b128 v[44:47], v6 offset:37440
    s_mov_b32 s58, s67
    v_mfma_f32_16x16x32_bf16 v[156:159], v[108:111], v[128:131], v[156:159]
    buffer_load_dwordx4 v11, s[20:23], s58 offen lds
    v_mfma_f32_16x16x32_bf16 v[160:163], v[112:115], v[128:131], v[160:163]
    v_mfma_f32_16x16x32_bf16 v[164:167], v[116:119], v[128:131], v[164:167]
    s_waitcnt vmcnt(9) lgkmcnt(0)
    v_mfma_f32_16x16x32_bf16 v[136:139], v[12:15], v[120:123], v[136:139]
    ds_read_b64_tr_b16 v[128:129], v5 offset:16384
    v_mfma_f32_16x16x32_bf16 v[136:139], v[16:19], v[124:127], v[136:139]
    s_barrier
    ds_read_b64_tr_b16 v[130:131], v5 offset:16896
    v_mfma_f32_16x16x32_bf16 v[140:143], v[16:19], v[120:123], v[140:143]
    s_add_u32 m0, s52, 40960
    v_mfma_f32_16x16x32_bf16 v[140:143], v[20:23], v[124:127], v[140:143]
    ds_read_b64_tr_b16 v[132:133], v5 offset:24576
    v_mfma_f32_16x16x32_bf16 v[144:147], v[20:23], v[120:123], v[144:147]
    s_add_u32 s57, s62, 2621440
    v_mfma_f32_16x16x32_bf16 v[144:147], v[24:27], v[124:127], v[144:147]
    ds_read_b64_tr_b16 v[134:135], v5 offset:25088
    v_mfma_f32_16x16x32_bf16 v[148:151], v[24:27], v[120:123], v[148:151]
    buffer_load_dwordx4 v8, s[24:27], s57 offen lds
    v_mfma_f32_16x16x32_bf16 v[148:151], v[28:31], v[124:127], v[148:151]
    ds_read_b128 v[48:51], v6 offset:37696
    v_mfma_f32_16x16x32_bf16 v[152:155], v[28:31], v[120:123], v[152:155]
    ds_read_b128 v[52:55], v6 offset:37952
    s_add_u32 m0, s52, 49152
    v_mfma_f32_16x16x32_bf16 v[152:155], v[32:35], v[124:127], v[152:155]
    v_mfma_f32_16x16x32_bf16 v[156:159], v[32:35], v[120:123], v[156:159]
    ds_read_b128 v[56:59], v6 offset:38208
    s_add_u32 s57, s62, 3670016
    v_mfma_f32_16x16x32_bf16 v[156:159], v[36:39], v[124:127], v[156:159]
    v_mfma_f32_16x16x32_bf16 v[160:163], v[36:39], v[120:123], v[160:163]
    ds_read_b128 v[60:63], v6 offset:38480
    buffer_load_dwordx4 v8, s[24:27], s57 offen lds
    v_mfma_f32_16x16x32_bf16 v[160:163], v[40:43], v[124:127], v[160:163]
    v_mfma_f32_16x16x32_bf16 v[164:167], v[40:43], v[120:123], v[164:167]
    v_mfma_f32_16x16x32_bf16 v[164:167], v[44:47], v[124:127], v[164:167]
    s_waitcnt vmcnt(7) lgkmcnt(0)
    v_mfma_f32_16x16x32_bf16 v[136:139], v[20:23], v[128:131], v[136:139]
    ds_read_b64_tr_b16 v[120:121], v5 offset:32768
    v_mfma_f32_16x16x32_bf16 v[136:139], v[24:27], v[132:135], v[136:139]
    s_barrier
    ds_read_b64_tr_b16 v[122:123], v5 offset:33280
    v_mfma_f32_16x16x32_bf16 v[140:143], v[24:27], v[128:131], v[140:143]
    s_add_u32 m0, s52, 57344
    v_mfma_f32_16x16x32_bf16 v[140:143], v[28:31], v[132:135], v[140:143]
    ds_read_b64_tr_b16 v[124:125], v7 offset:0
    v_mfma_f32_16x16x32_bf16 v[144:147], v[28:31], v[128:131], v[144:147]
    s_add_u32 s57, s62, 4718592
    v_mfma_f32_16x16x32_bf16 v[144:147], v[32:35], v[132:135], v[144:147]
    ds_read_b64_tr_b16 v[126:127], v7 offset:512
    v_mfma_f32_16x16x32_bf16 v[148:151], v[32:35], v[128:131], v[148:151]
    buffer_load_dwordx4 v8, s[24:27], s57 offen lds
    v_mfma_f32_16x16x32_bf16 v[148:151], v[36:39], v[132:135], v[148:151]
    ds_read_b128 v[64:67], v6 offset:38736
    v_mfma_f32_16x16x32_bf16 v[152:155], v[36:39], v[128:131], v[152:155]
    ds_read_b128 v[68:71], v6 offset:38992
    s_add_u32 m0, s52, 65536
    v_mfma_f32_16x16x32_bf16 v[152:155], v[40:43], v[132:135], v[152:155]
    v_mfma_f32_16x16x32_bf16 v[156:159], v[40:43], v[128:131], v[156:159]
    ds_read_b128 v[72:75], v6 offset:36000
    s_add_u32 s57, s62, 5767168
    v_mfma_f32_16x16x32_bf16 v[156:159], v[44:47], v[132:135], v[156:159]
    v_mfma_f32_16x16x32_bf16 v[160:163], v[44:47], v[128:131], v[160:163]
    ds_read_b128 v[76:79], v6 offset:36256
    buffer_load_dwordx4 v8, s[24:27], s57 offen lds
    v_mfma_f32_16x16x32_bf16 v[160:163], v[48:51], v[132:135], v[160:163]
    v_mfma_f32_16x16x32_bf16 v[164:167], v[48:51], v[128:131], v[164:167]
    v_mfma_f32_16x16x32_bf16 v[164:167], v[52:55], v[132:135], v[164:167]
    s_waitcnt vmcnt(5) lgkmcnt(0)
    v_mfma_f32_16x16x32_bf16 v[136:139], v[28:31], v[120:123], v[136:139]
    ds_read_b64_tr_b16 v[128:129], v7 offset:8192
    v_mfma_f32_16x16x32_bf16 v[136:139], v[32:35], v[124:127], v[136:139]
    s_barrier
    ds_read_b64_tr_b16 v[130:131], v7 offset:8704
    s_add_u32 m0, s52, 73728
    v_mfma_f32_16x16x32_bf16 v[140:143], v[32:35], v[120:123], v[140:143]
    v_mfma_f32_16x16x32_bf16 v[140:143], v[36:39], v[124:127], v[140:143]
    ds_read_b64_tr_b16 v[132:133], v7 offset:16384
    s_add_u32 s57, s62, 6815744
    v_mfma_f32_16x16x32_bf16 v[144:147], v[36:39], v[120:123], v[144:147]
    v_mfma_f32_16x16x32_bf16 v[144:147], v[40:43], v[124:127], v[144:147]
    ds_read_b64_tr_b16 v[134:135], v7 offset:16896
    buffer_load_dwordx4 v8, s[24:27], s57 offen lds
    v_mfma_f32_16x16x32_bf16 v[148:151], v[40:43], v[120:123], v[148:151]
    v_mfma_f32_16x16x32_bf16 v[148:151], v[44:47], v[124:127], v[148:151]
    ds_read_b128 v[12:15], v6 offset:35488
    s_cmp_eq_u32 s56, 3
    s_cselect_b32 s26, 0, s26
    v_mfma_f32_16x16x32_bf16 v[152:155], v[44:47], v[120:123], v[152:155]
    ds_read_b128 v[16:19], v6 offset:35744
    v_mfma_f32_16x16x32_bf16 v[152:155], v[48:51], v[124:127], v[152:155]
    s_add_u32 m0, s52, 0
    v_mfma_f32_16x16x32_bf16 v[156:159], v[48:51], v[120:123], v[156:159]
    ds_read_b128 v[80:83], v6 offset:36528
    v_mfma_f32_16x16x32_bf16 v[156:159], v[52:55], v[124:127], v[156:159]
    s_add_u32 s57, s63, 0
    v_mfma_f32_16x16x32_bf16 v[160:163], v[52:55], v[120:123], v[160:163]
    ds_read_b128 v[84:87], v6 offset:36784
    v_mfma_f32_16x16x32_bf16 v[160:163], v[56:59], v[124:127], v[160:163]
    buffer_load_dwordx4 v8, s[24:27], s57 offen lds
    v_mfma_f32_16x16x32_bf16 v[164:167], v[56:59], v[120:123], v[164:167]
    v_mfma_f32_16x16x32_bf16 v[164:167], v[60:63], v[124:127], v[164:167]
    s_waitcnt vmcnt(4) lgkmcnt(0)
    v_mfma_f32_16x16x32_bf16 v[136:139], v[36:39], v[128:131], v[136:139]
    ds_read_b64_tr_b16 v[120:121], v7 offset:24576
    v_mfma_f32_16x16x32_bf16 v[136:139], v[40:43], v[132:135], v[136:139]
    s_barrier
    ds_read_b64_tr_b16 v[122:123], v7 offset:25088
    v_mfma_f32_16x16x32_bf16 v[140:143], v[40:43], v[128:131], v[140:143]
    s_add_u32 m0, s52, 8192
    v_mfma_f32_16x16x32_bf16 v[140:143], v[44:47], v[132:135], v[140:143]
    ds_read_b64_tr_b16 v[124:125], v7 offset:32768
    v_mfma_f32_16x16x32_bf16 v[144:147], v[44:47], v[128:131], v[144:147]
    s_add_u32 s57, s63, 1048576
    v_mfma_f32_16x16x32_bf16 v[144:147], v[48:51], v[132:135], v[144:147]
    ds_read_b64_tr_b16 v[126:127], v7 offset:33280
    v_mfma_f32_16x16x32_bf16 v[148:151], v[48:51], v[128:131], v[148:151]
    buffer_load_dwordx4 v8, s[24:27], s57 offen lds
    v_mfma_f32_16x16x32_bf16 v[148:151], v[52:55], v[132:135], v[148:151]
    ds_read_b128 v[88:91], v6 offset:37040
    v_mfma_f32_16x16x32_bf16 v[152:155], v[52:55], v[128:131], v[152:155]
    ds_read_b128 v[92:95], v6 offset:37296
    s_add_u32 m0, s52, 16384
    v_mfma_f32_16x16x32_bf16 v[152:155], v[56:59], v[132:135], v[152:155]
    v_mfma_f32_16x16x32_bf16 v[156:159], v[56:59], v[128:131], v[156:159]
    ds_read_b128 v[96:99], v6 offset:37568
    s_add_u32 s57, s63, 2097152
    v_mfma_f32_16x16x32_bf16 v[156:159], v[60:63], v[132:135], v[156:159]
    v_mfma_f32_16x16x32_bf16 v[160:163], v[60:63], v[128:131], v[160:163]
    ds_read_b128 v[100:103], v6 offset:37824
    buffer_load_dwordx4 v8, s[24:27], s57 offen lds
    v_mfma_f32_16x16x32_bf16 v[160:163], v[64:67], v[132:135], v[160:163]
    v_mfma_f32_16x16x32_bf16 v[164:167], v[64:67], v[128:131], v[164:167]
    v_mfma_f32_16x16x32_bf16 v[164:167], v[68:71], v[132:135], v[164:167]
    s_waitcnt vmcnt(4) lgkmcnt(0)
    v_mfma_f32_16x16x32_bf16 v[136:139], v[12:15], v[120:123], v[136:139]
    ds_read_b64_tr_b16 v[128:129], v5 offset:0
    v_mfma_f32_16x16x32_bf16 v[136:139], v[16:19], v[124:127], v[136:139]
    s_barrier
    ds_read_b64_tr_b16 v[130:131], v5 offset:512
    v_mfma_f32_16x16x32_bf16 v[140:143], v[16:19], v[120:123], v[140:143]
    s_add_u32 m0, s52, 24576
    v_mfma_f32_16x16x32_bf16 v[140:143], v[72:75], v[124:127], v[140:143]
    ds_read_b64_tr_b16 v[132:133], v5 offset:8192
    v_mfma_f32_16x16x32_bf16 v[144:147], v[72:75], v[120:123], v[144:147]
    s_add_u32 s57, s63, 3145728
    v_mfma_f32_16x16x32_bf16 v[144:147], v[76:79], v[124:127], v[144:147]
    ds_read_b64_tr_b16 v[134:135], v5 offset:8704
    v_mfma_f32_16x16x32_bf16 v[148:151], v[76:79], v[120:123], v[148:151]
    buffer_load_dwordx4 v8, s[24:27], s57 offen lds
    v_mfma_f32_16x16x32_bf16 v[148:151], v[80:83], v[124:127], v[148:151]
    ds_read_b128 v[104:107], v6 offset:38080
    v_mfma_f32_16x16x32_bf16 v[152:155], v[80:83], v[120:123], v[152:155]
    ds_read_b128 v[108:111], v6 offset:38336
    s_add_u32 m0, s52, 32768
    v_mfma_f32_16x16x32_bf16 v[152:155], v[84:87], v[124:127], v[152:155]
    v_mfma_f32_16x16x32_bf16 v[156:159], v[84:87], v[120:123], v[156:159]
    ds_read_b128 v[112:115], v6 offset:38608
    s_add_u32 s57, s63, 4194304
    v_mfma_f32_16x16x32_bf16 v[156:159], v[88:91], v[124:127], v[156:159]
    v_mfma_f32_16x16x32_bf16 v[160:163], v[88:91], v[120:123], v[160:163]
    ds_read_b128 v[116:119], v6 offset:38864
    buffer_load_dwordx4 v8, s[24:27], s57 offen lds
    v_mfma_f32_16x16x32_bf16 v[160:163], v[92:95], v[124:127], v[160:163]
    v_mfma_f32_16x16x32_bf16 v[164:167], v[92:95], v[120:123], v[164:167]
    v_mfma_f32_16x16x32_bf16 v[164:167], v[96:99], v[124:127], v[164:167]
    s_waitcnt vmcnt(5) lgkmcnt(0)
    v_mfma_f32_16x16x32_bf16 v[136:139], v[72:75], v[128:131], v[136:139]
    ds_read_b64_tr_b16 v[120:121], v5 offset:16384
    v_mfma_f32_16x16x32_bf16 v[136:139], v[76:79], v[132:135], v[136:139]
    s_barrier
    ds_read_b64_tr_b16 v[122:123], v5 offset:16896
    s_add_u32 m0, s52, 40960
    v_mfma_f32_16x16x32_bf16 v[140:143], v[76:79], v[128:131], v[140:143]
    s_add_u32 s57, s63, 5242880
    v_mfma_f32_16x16x32_bf16 v[140:143], v[80:83], v[132:135], v[140:143]
    ds_read_b64_tr_b16 v[124:125], v5 offset:24576
    buffer_load_dwordx4 v8, s[24:27], s57 offen lds
    v_mfma_f32_16x16x32_bf16 v[144:147], v[80:83], v[128:131], v[144:147]
    s_add_u32 m0, s53, 35360
    v_mfma_f32_16x16x32_bf16 v[144:147], v[84:87], v[132:135], v[144:147]
    ds_read_b64_tr_b16 v[126:127], v5 offset:25088
    s_add_u32 s58, s68, 0
    v_mfma_f32_16x16x32_bf16 v[148:151], v[84:87], v[128:131], v[148:151]
    buffer_load_dwordx4 v9, s[20:23], s58 offen lds
    v_mfma_f32_16x16x32_bf16 v[148:151], v[88:91], v[132:135], v[148:151]
    ds_read_b128 v[12:15], v6 offset:0
    v_mfma_f32_16x16x32_bf16 v[152:155], v[88:91], v[128:131], v[152:155]
    ds_read_b128 v[16:19], v6 offset:256
    s_add_u32 m0, s52, 49152
    v_mfma_f32_16x16x32_bf16 v[152:155], v[92:95], v[132:135], v[152:155]
    s_add_u32 s57, s63, 6291456
    v_mfma_f32_16x16x32_bf16 v[156:159], v[92:95], v[128:131], v[156:159]
    ds_read_b128 v[20:23], v6 offset:512
    buffer_load_dwordx4 v8, s[24:27], s57 offen lds
    v_mfma_f32_16x16x32_bf16 v[156:159], v[96:99], v[132:135], v[156:159]
    s_add_u32 m0, s53, 43680
    v_mfma_f32_16x16x32_bf16 v[160:163], v[96:99], v[128:131], v[160:163]
    ds_read_b128 v[24:27], v6 offset:768
    s_add_u32 s58, s68, 65536
    v_mfma_f32_16x16x32_bf16 v[160:163], v[100:103], v[132:135], v[160:163]
    buffer_load_dwordx4 v9, s[20:23], s58 offen lds
    v_mfma_f32_16x16x32_bf16 v[164:167], v[100:103], v[128:131], v[164:167]
    v_mfma_f32_16x16x32_bf16 v[164:167], v[104:107], v[132:135], v[164:167]
    s_waitcnt vmcnt(7) lgkmcnt(0)
    v_mfma_f32_16x16x32_bf16 v[136:139], v[80:83], v[120:123], v[136:139]
    ds_read_b64_tr_b16 v[128:129], v5 offset:32768
    v_mfma_f32_16x16x32_bf16 v[136:139], v[84:87], v[124:127], v[136:139]
    s_barrier
    s_add_u32 m0, s52, 57344
    v_mfma_f32_16x16x32_bf16 v[140:143], v[84:87], v[120:123], v[140:143]
    ds_read_b64_tr_b16 v[130:131], v5 offset:33280
    s_add_u32 s57, s63, 7340032
    v_mfma_f32_16x16x32_bf16 v[140:143], v[88:91], v[124:127], v[140:143]
    buffer_load_dwordx4 v8, s[24:27], s57 offen lds
    v_mfma_f32_16x16x32_bf16 v[144:147], v[88:91], v[120:123], v[144:147]
    ds_read_b128 v[28:31], v6 offset:1040
    s_add_u32 m0, s53, 52000
    v_mfma_f32_16x16x32_bf16 v[144:147], v[92:95], v[124:127], v[144:147]
    s_add_u32 s58, s68, 131072
    v_mfma_f32_16x16x32_bf16 v[148:151], v[92:95], v[120:123], v[148:151]
    buffer_load_dwordx4 v9, s[20:23], s58 offen lds
    v_mfma_f32_16x16x32_bf16 v[148:151], v[96:99], v[124:127], v[148:151]
    ds_read_b128 v[32:35], v6 offset:1296
    v_mfma_f32_16x16x32_bf16 v[152:155], v[96:99], v[120:123], v[152:155]
    s_add_u32 m0, s52, 65536
    v_mfma_f32_16x16x32_bf16 v[152:155], v[100:103], v[124:127], v[152:155]
    ds_read_b128 v[36:39], v6 offset:1552
    s_add_u32 s57, s63, 524288
    v_mfma_f32_16x16x32_bf16 v[156:159], v[100:103], v[120:123], v[156:159]
    buffer_load_dwordx4 v8, s[24:27], s57 offen lds
    v_mfma_f32_16x16x32_bf16 v[156:159], v[104:107], v[124:127], v[156:159]
    ds_read_b128 v[40:43], v6 offset:1808
    s_add_u32 m0, s53, 60320
    v_mfma_f32_16x16x32_bf16 v[160:163], v[104:107], v[120:123], v[160:163]
    s_add_u32 s58, s68, 196608
    v_mfma_f32_16x16x32_bf16 v[160:163], v[108:111], v[124:127], v[160:163]
    buffer_load_dwordx4 v9, s[20:23], s58 offen lds
    v_mfma_f32_16x16x32_bf16 v[164:167], v[108:111], v[120:123], v[164:167]
    v_mfma_f32_16x16x32_bf16 v[164:167], v[112:115], v[124:127], v[164:167]
    s_waitcnt vmcnt(9) lgkmcnt(0)
    v_mfma_f32_16x16x32_bf16 v[136:139], v[88:91], v[128:131], v[136:139]
    ds_read_b64_tr_b16 v[120:121], v7 offset:0
    v_mfma_f32_16x16x32_bf16 v[140:143], v[92:95], v[128:131], v[140:143]
    s_barrier
    ds_read_b64_tr_b16 v[122:123], v7 offset:512
    s_add_u32 m0, s52, 73728
    v_mfma_f32_16x16x32_bf16 v[144:147], v[96:99], v[128:131], v[144:147]
    ds_read_b64_tr_b16 v[124:125], v7 offset:8192
    s_add_u32 s57, s63, 1572864
    v_mfma_f32_16x16x32_bf16 v[148:151], v[100:103], v[128:131], v[148:151]
    ds_read_b64_tr_b16 v[126:127], v7 offset:8704
    buffer_load_dwordx4 v8, s[24:27], s57 offen lds
    s_add_u32 m0, s54, 35360
    v_mfma_f32_16x16x32_bf16 v[152:155], v[104:107], v[128:131], v[152:155]
    ds_read_b128 v[44:47], v6 offset:2080
    s_mov_b32 s58, s68
    v_mfma_f32_16x16x32_bf16 v[156:159], v[108:111], v[128:131], v[156:159]
    buffer_load_dwordx4 v11, s[20:23], s58 offen lds
    v_mfma_f32_16x16x32_bf16 v[160:163], v[112:115], v[128:131], v[160:163]
    v_mfma_f32_16x16x32_bf16 v[164:167], v[116:119], v[128:131], v[164:167]
    s_add_u32 s55, s55, 2
    s_add_u32 s57, s55, 0
    s_and_b32 s57, s57, 7
    s_lshl_b32 s61, s57, 16
    s_lshl_b32 s65, s57, 7
    s_add_u32 s57, s55, 1
    s_and_b32 s57, s57, 7
    s_lshl_b32 s62, s57, 16
    s_lshl_b32 s66, s57, 7
    s_add_u32 s57, s55, 2
    s_and_b32 s57, s57, 7
    s_lshl_b32 s63, s57, 16
    s_lshl_b32 s67, s57, 7
    s_add_u32 s57, s55, 3
    s_and_b32 s57, s57, 7
    s_lshl_b32 s64, s57, 16
    s_lshl_b32 s68, s57, 7
    s_add_u32 s56, s56, 1
    s_cmp_lt_u32 s56, 4
    s_cbranch_scc1 L_loop0
    s_waitcnt lgkmcnt(0)
    s_cmp_eq_u32 s50, 0
    s_cbranch_scc0 L_ex1
    ds_write_b128 v2, v[152:155] offset:0
    ds_write_b128 v2, v[156:159] offset:1024
    ds_write_b128 v2, v[160:163] offset:2048
    ds_write_b128 v2, v[164:167] offset:3072
    s_branch L_ex2
L_ex1:
    ds_write_b128 v2, v[136:139] offset:0
    ds_write_b128 v2, v[140:143] offset:1024
    ds_write_b128 v2, v[144:147] offset:2048
    ds_write_b128 v2, v[148:151] offset:3072
    s_nop 1
    v_mov_b32 v136, v152
    v_mov_b32 v137, v153
    v_mov_b32 v138, v154
    v_mov_b32 v139, v155
    v_mov_b32 v140, v156
    v_mov_b32 v141, v157
    v_mov_b32 v142, v158
    v_mov_b32 v143, v159
    v_mov_b32 v144, v160
    v_mov_b32 v145, v161
    v_mov_b32 v146, v162
    v_mov_b32 v147, v163
    v_mov_b32 v148, v164
    v_mov_b32 v149, v165
    v_mov_b32 v150, v166
    v_mov_b32 v151, v167
L_ex2:
    v_lshl_or_b32 v0, v1, 16, v0
    v_mbcnt_lo_u32_b32 v1, -1, 0
    v_mbcnt_hi_u32_b32 v1, -1, v1
    v_lshlrev_b32 v10, 16, v10
    v_and_b32 v74, 15, v1
    s_lshl_b32 s57, s51, 6
    s_add_u32 s57, s57, 35360
    v_lshl_add_u32 v75, v74, 2, s57
    v_lshl_add_u32 v75, v4, 8, v75
    s_lshl_b32 s57, s50, 9
    s_lshl_b32 s58, s51, 7
    s_add_u32 s57, s57, s58
    v_lshl_add_u32 v76, v74, 3, s57
    v_cvt_f32_u32 v77, s70
    v_rcp_f32 v77, v77
    v_pk_add_f32 v[28:29], v[136:137], v[10:11] op_sel_hi:[1,0]
    v_pk_add_f32 v[30:31], v[138:139], v[10:11] op_sel_hi:[1,0]
    v_pk_add_f32 v[32:33], v[140:141], v[10:11] op_sel_hi:[1,0]
    v_pk_add_f32 v[34:35], v[142:143], v[10:11] op_sel_hi:[1,0]
    v_pk_add_f32 v[36:37], v[144:145], v[10:11] op_sel_hi:[1,0]
    v_pk_add_f32 v[38:39], v[146:147], v[10:11] op_sel_hi:[1,0]
    v_pk_add_f32 v[40:41], v[148:149], v[10:11] op_sel_hi:[1,0]
    v_pk_add_f32 v[42:43], v[150:151], v[10:11] op_sel_hi:[1,0]
    s_waitcnt vmcnt(0) lgkmcnt(0)
    s_barrier
    ds_read_b128 v[12:15], v3 offset:0
    ds_read_b128 v[16:19], v3 offset:1024
    ds_read_b128 v[20:23], v3 offset:2048
    ds_read_b128 v[24:27], v3 offset:3072
    s_waitcnt lgkmcnt(3)
    v_pk_add_f32 v[28:29], v[28:29], v[12:13]
    v_pk_add_f32 v[30:31], v[30:31], v[14:15]
    s_waitcnt lgkmcnt(2)
    v_pk_add_f32 v[32:33], v[32:33], v[16:17]
    v_pk_add_f32 v[34:35], v[34:35], v[18:19]
    s_waitcnt lgkmcnt(1)
    v_pk_add_f32 v[36:37], v[36:37], v[20:21]
    v_pk_add_f32 v[38:39], v[38:39], v[22:23]
    s_waitcnt lgkmcnt(0)
    v_pk_add_f32 v[40:41], v[40:41], v[24:25]
    v_pk_add_f32 v[42:43], v[42:43], v[26:27]
    v_cndmask_b32 v44, 0, v28, s[4:5]
    v_cndmask_b32 v45, 0, v29, s[6:7]
    v_cndmask_b32 v46, 0, v30, s[8:9]
    v_cndmask_b32 v47, 0, v31, s[10:11]
    v_cndmask_b32 v48, 0, v32, s[12:13]
    v_cndmask_b32 v49, 0, v33, s[14:15]
    v_cndmask_b32 v50, 0, v34, s[16:17]
    v_cndmask_b32 v51, 0, v35, s[18:19]
    v_cndmask_b32 v52, 0, v36, s[72:73]
    v_cndmask_b32 v53, 0, v37, s[74:75]
    v_cndmask_b32 v54, 0, v38, s[76:77]
    v_cndmask_b32 v55, 0, v39, s[78:79]
    v_cndmask_b32 v56, 0, v40, s[80:81]
    v_cndmask_b32 v57, 0, v41, s[82:83]
    v_cndmask_b32 v58, 0, v42, s[84:85]
    v_cndmask_b32 v59, 0, v43, s[86:87]
    v_pk_add_f32 v[44:45], v[44:45], v[52:53]
    v_pk_add_f32 v[46:47], v[46:47], v[54:55]
    v_pk_add_f32 v[48:49], v[48:49], v[56:57]
    v_pk_add_f32 v[50:51], v[50:51], v[58:59]
    v_pk_add_f32 v[44:45], v[44:45], v[48:49]
    v_pk_add_f32 v[46:47], v[46:47], v[50:51]
    v_pk_add_f32 v[44:45], v[44:45], v[46:47]
    v_add_f32 v72, v44, v45
    v_mov_b32 v78, v72
    v_mov_b32 v79, v72
    s_nop 1
    v_permlane32_swap_b32 v78, v79
    s_nop 1
    v_add_f32 v72, v78, v79
    v_mov_b32 v78, v72
    v_mov_b32 v79, v72
    s_nop 1
    v_permlane16_swap_b32 v78, v79
    s_nop 1
    v_add_f32 v72, v78, v79
    v_mul_f32 v112, v72, v77
    v_pk_add_f32 v[44:45], v[28:29], v[112:113] op_sel_hi:[1,0] neg_lo:[0,1] neg_hi:[0,1]
    v_pk_add_f32 v[46:47], v[30:31], v[112:113] op_sel_hi:[1,0] neg_lo:[0,1] neg_hi:[0,1]
    v_pk_add_f32 v[48:49], v[32:33], v[112:113] op_sel_hi:[1,0] neg_lo:[0,1] neg_hi:[0,1]
    v_pk_add_f32 v[50:51], v[34:35], v[112:113] op_sel_hi:[1,0] neg_lo:[0,1] neg_hi:[0,1]
    v_pk_add_f32 v[52:53], v[36:37], v[112:113] op_sel_hi:[1,0] neg_lo:[0,1] neg_hi:[0,1]
    v_pk_add_f32 v[54:55], v[38:39], v[112:113] op_sel_hi:[1,0] neg_lo:[0,1] neg_hi:[0,1]
    v_pk_add_f32 v[56:57], v[40:41], v[112:113] op_sel_hi:[1,0] neg_lo:[0,1] neg_hi:[0,1]
    v_pk_add_f32 v[58:59], v[42:43], v[112:113] op_sel_hi:[1,0] neg_lo:[0,1] neg_hi:[0,1]
    v_cndmask_b32 v44, 0, v44, s[4:5]
    v_cndmask_b32 v45, 0, v45, s[6:7]
    v_cndmask_b32 v46, 0, v46, s[8:9]
    v_cndmask_b32 v47, 0, v47, s[10:11]
    v_cndmask_b32 v48, 0, v48, s[12:13]
    v_cndmask_b32 v49, 0, v49, s[14:15]
    v_cndmask_b32 v50, 0, v50, s[16:17]
    v_cndmask_b32 v51, 0, v51, s[18:19]
    v_cndmask_b32 v52, 0, v52, s[72:73]
    v_cndmask_b32 v53, 0, v53, s[74:75]
    v_cndmask_b32 v54, 0, v54, s[76:77]
    v_cndmask_b32 v55, 0, v55, s[78:79]
    v_cndmask_b32 v56, 0, v56, s[80:81]
    v_cndmask_b32 v57, 0, v57, s[82:83]
    v_cndmask_b32 v58, 0, v58, s[84:85]
    v_cndmask_b32 v59, 0, v59, s[86:87]
    v_pk_mul_f32 v[44:45], v[44:45], v[44:45]
    v_pk_mul_f32 v[46:47], v[46:47], v[46:47]
    v_pk_mul_f32 v[48:49], v[48:49], v[48:49]
    v_pk_mul_f32 v[50:51], v[50:51], v[50:51]
    v_pk_fma_f32 v[44:45], v[52:53], v[52:53], v[44:45]
    v_pk_fma_f32 v[46:47], v[54:55], v[54:55], v[46:47]
    v_pk_fma_f32 v[48:49], v[56:57], v[56:57], v[48:49]
    v_pk_fma_f32 v[50:51], v[58:59], v[58:59], v[50:51]
    v_pk_add_f32 v[44:45], v[44:45], v[48:49]
    v_pk_add_f32 v[46:47], v[46:47], v[50:51]
    v_pk_add_f32 v[44:45], v[44:45], v[46:47]
    v_add_f32 v73, v44, v45
    v_mov_b32 v78, v73
    v_mov_b32 v79, v73
    s_nop 1
    v_permlane32_swap_b32 v78, v79
    s_nop 1
    v_add_f32 v73, v78, v79
    v_mov_b32 v78, v73
    v_mov_b32 v79, v73
    s_nop 1
    v_permlane16_swap_b32 v78, v79
    s_nop 1
    v_add_f32 v73, v78, v79
    ds_write_b64 v76, v[72:73] offset:0
    ds_write_b32 v75, v28 offset:0
    ds_write_b32 v75, v29 offset:2048
    ds_write_b32 v75, v30 offset:4096
    ds_write_b32 v75, v31 offset:6144
    ds_write_b32 v75, v32 offset:256
    ds_write_b32 v75, v33 offset:2304
    ds_write_b32 v75, v34 offset:4352
    ds_write_b32 v75, v35 offset:6400
    ds_write_b32 v75, v36 offset:512
    ds_write_b32 v75, v37 offset:2560
    ds_write_b32 v75, v38 offset:4608
    ds_write_b32 v75, v39 offset:6656
    ds_write_b32 v75, v40 offset:768
    ds_write_b32 v75, v41 offset:2816
    ds_write_b32 v75, v42 offset:4864
    ds_write_b32 v75, v43 offset:6912
    v_lshrrev_b32 v74, 3, v1
    v_and_b32 v75, 7, v1
    s_lshl_b32 s57, s49, 12
    s_add_u32 s57, s57, 35360
    v_lshl_add_u32 v76, v74, 8, s57
    v_lshl_add_u32 v76, v75, 5, v76
    s_waitcnt lgkmcnt(0)
    s_barrier
    s_cmp_lg_u32 s49, 0
    s_cbranch_scc1 L_notw0
    v_lshlrev_b32 v77, 3, v1
    ds_read_b64 v[44:45], v77 offset:0
    ds_read_b64 v[46:47], v77 offset:512
    s_lshl_b32 s57, s71, 2
    v_mov_b32 v79, s57
    buffer_load_dword v56, v79, s[40:43], 0 offen offset:0 sc1
    s_cmp_eq_u32 s48, 15
    s_cselect_b32 s57, 37, 64
    s_cselect_b32 s58, 36, 64
    v_cvt_f32_u32 v48, s57
    v_cvt_f32_u32 v49, s58
    v_cvt_f32_u32 v50, s69
    v_rcp_f32 v51, v48
    v_rcp_f32 v52, v49
    v_rcp_f32 v53, v50
    s_lshl_b32 s57, s71, 13
    s_lshl_b32 s58, s48, 9
    s_add_u32 s58, s58, s57
    v_add_u32 v78, s57, v77
    v_add_u32 v77, s58, v77
    s_waitcnt lgkmcnt(0)
    v_add_f32 v72, v44, v46
    v_mul_f32 v53, v72, v53
    v_add_f32 v73, v45, v47
    v_fma_f32 v54, v44, v51, -v53
    v_fma_f32 v55, v46, v52, -v53
    v_mul_f32 v54, v54, v54
    v_mul_f32 v55, v55, v55
    v_fmac_f32 v73, v54, v48
    v_fmac_f32 v73, v55, v49
    v_max_f32 v73, 0, v73
    v_and_b32 v73, 0x7fffffff, v73
    buffer_store_dwordx2 v[72:73], v77, s[28:31], 0 offen sc1
    s_mov_b32 s59, 0
    s_movk_i32 s60, 4096
    s_waitcnt vmcnt(1)
L_pollA:
    v_readfirstlane_b32 s58, v56
    s_add_u32 s59, s59, 1
    s_cmp_ge_u32 s58, 16
    s_cbranch_scc1 L_pollB
    buffer_load_dword v56, v79, s[40:43], 0 offen offset:0 sc1
    s_waitcnt vmcnt(0)
    s_cmp_lt_u32 s59, 0x400000
    s_cbranch_scc1 L_pollA
L_pollB:
    buffer_load_dwordx2 v[80:81], v78, s[28:31], 0 offen offset:0 sc1
    buffer_load_dwordx2 v[82:83], v78, s[28:31], 0 offen offset:512 sc1
    buffer_load_dwordx2 v[84:85], v78, s[28:31], 0 offen offset:1024 sc1
    buffer_load_dwordx2 v[86:87], v78, s[28:31], 0 offen offset:1536 sc1
    buffer_load_dwordx2 v[88:89], v78, s[28:31], 0 offen offset:2048 sc1
    buffer_load_dwordx2 v[90:91], v78, s[28:31], 0 offen offset:2560 sc1
    buffer_load_dwordx2 v[92:93], v78, s[28:31], 0 offen offset:3072 sc1
    buffer_load_dwordx2 v[94:95], v78, s[28:31], 0 offen offset:3584 sc1
    buffer_load_dwordx2 v[96:97], v78, s[28:31], s60 offen offset:0 sc1
    buffer_load_dwordx2 v[98:99], v78, s[28:31], s60 offen offset:512 sc1
    buffer_load_dwordx2 v[100:101], v78, s[28:31], s60 offen offset:1024 sc1
    buffer_load_dwordx2 v[102:103], v78, s[28:31], s60 offen offset:1536 sc1
    buffer_load_dwordx2 v[104:105], v78, s[28:31], s60 offen offset:2048 sc1
    buffer_load_dwordx2 v[106:107], v78, s[28:31], s60 offen offset:2560 sc1
    buffer_load_dwordx2 v[108:109], v78, s[28:31], s60 offen offset:3072 sc1
    buffer_load_dwordx2 v[110:111], v78, s[28:31], s60 offen offset:3584 sc1
    s_waitcnt vmcnt(0)
    v_or3_b32 v44, v81, v83, v85
    v_or3_b32 v45, v87, v89, v91
    v_or3_b32 v46, v93, v95, v97
    v_or3_b32 v47, v99, v101, v103
    v_or3_b32 v48, v105, v107, v109
    v_or3_b32 v44, v44, v45, v111
    v_or3_b32 v46, v46, v47, v48
    v_or_b32 v44, v44, v46
    v_cmp_gt_i32 vcc, 0, v44
    s_add_u32 s59, s59, 1
    s_nop 3
    s_cbranch_vccz L_got
    s_cmp_lt_u32 s59, 0x400000
    s_cbranch_scc1 L_pollB
L_got:
    v_pk_add_f32 v[44:45], v[80:81], v[96:97]
    v_pk_add_f32 v[46:47], v[82:83], v[98:99]
    v_pk_add_f32 v[48:49], v[84:85], v[100:101]
    v_pk_add_f32 v[50:51], v[86:87], v[102:103]
    v_pk_add_f32 v[52:53], v[88:89], v[104:105]
    v_pk_add_f32 v[54:55], v[90:91], v[106:107]
    v_pk_add_f32 v[56:57], v[92:93], v[108:109]
    v_pk_add_f32 v[58:59], v[94:95], v[110:111]
    v_pk_add_f32 v[44:45], v[44:45], v[52:53]
    v_pk_add_f32 v[46:47], v[46:47], v[54:55]
    v_pk_add_f32 v[48:49], v[48:49], v[56:57]
    v_pk_add_f32 v[50:51], v[50:51], v[58:59]
    v_pk_add_f32 v[44:45], v[44:45], v[48:49]
    v_pk_add_f32 v[46:47], v[46:47], v[50:51]
    v_pk_add_f32 v[44:45], v[44:45], v[46:47]
    v_mul_f32 v44, 0x3a038849, v44
    s_mov_b32 s57, 0x3c000000
    s_mov_b32 s58, 0x3c607038
    v_fma_f32 v80, v80, s57, -v44
    v_fma_f32 v82, v82, s57, -v44
    v_fma_f32 v84, v84, s57, -v44
    v_fma_f32 v86, v86, s57, -v44
    v_fma_f32 v88, v88, s57, -v44
    v_fma_f32 v90, v90, s57, -v44
    v_fma_f32 v92, v92, s57, -v44
    v_fma_f32 v94, v94, s57, -v44
    v_fma_f32 v96, v96, s57, -v44
    v_fma_f32 v98, v98, s57, -v44
    v_fma_f32 v100, v100, s57, -v44
    v_fma_f32 v102, v102, s57, -v44
    v_fma_f32 v104, v104, s57, -v44
    v_fma_f32 v106, v106, s57, -v44
    v_fma_f32 v108, v108, s57, -v44
    v_fma_f32 v110, v110, s58, -v44
    v_mul_f32 v46, v80, v80
    v_mul_f32 v47, v82, v82
    v_mul_f32 v48, v84, v84
    v_mul_f32 v49, v86, v86
    v_fmac_f32 v46, v88, v88
    v_fmac_f32 v47, v90, v90
    v_fmac_f32 v48, v92, v92
    v_fmac_f32 v49, v94, v94
    v_fmac_f32 v46, v96, v96
    v_fmac_f32 v47, v98, v98
    v_fmac_f32 v48, v100, v100
    v_fmac_f32 v49, v102, v102
    v_fmac_f32 v46, v104, v104
    v_fmac_f32 v47, v106, v106
    v_fmac_f32 v48, v108, v108
    v_mul_f32 v110, v110, v110
    v_add_f32 v46, v46, v47
    v_add_f32 v48, v48, v49
    v_fmac_f32 v45, 0x42920000, v110
    v_add_f32 v46, v46, v48
    v_fmac_f32 v45, 0x43000000, v46
    v_mov_b32 v46, 0x3727c5ac
    v_fmac_f32 v46, 0x3a038849, v45
    v_rsq_f32 v46, v46
    v_lshlrev_b32 v47, 16, v0
    v_and_b32 v48, 0xffff0000, v0
    v_lshlrev_b32 v77, 2, v1
    v_mul_f32 v46, v46, v47
    v_fma_f32 v47, -v44, v46, v48
    ds_write_b32 v77, v46 offset:1024
    ds_write_b32 v77, v47 offset:1280
L_notw0:
    ds_read_b128 v[12:15], v76 offset:0
    ds_read_b128 v[16:19], v76 offset:16
    ds_read_b128 v[20:23], v76 offset:2048
    ds_read_b128 v[24:27], v76 offset:2064
    s_lshl_b32 s57, s49, 4
    s_lshl_b32 s58, s48, 7
    s_add_u32 s57, s57, s58
    v_add_u32 v74, s57, v74
    v_add_u32 v77, 8, v74
    s_mul_i32 s57, s46, 2040832
    s_lshl_b32 s58, s47, 7
    s_add_u32 s57, s57, s58
    v_lshl_add_u32 v78, v75, 4, s57
    v_lshl_add_u32 v114, v74, 10, v78
    v_lshl_add_u32 v115, v77, 10, v78
    v_mov_b32 v78, 0x7f000000
    s_movk_i32 s57, 1993
    v_cmp_gt_u32 vcc, s57, v74
    v_cmp_gt_u32 s[4:5], s57, v77
    v_lshlrev_b32 v75, 5, v75
    v_cndmask_b32 v114, v78, v114, vcc
    v_cndmask_b32 v115, v78, v115, s[4:5]
    v_mov_b32 v80, 0xc0135761
    v_mov_b32 v82, 0xbdd2d3e8
    v_mov_b32 v84, 1.0
    s_waitcnt lgkmcnt(0)
    s_barrier
    ds_read_b128 v[28:31], v75 offset:1024
    ds_read_b128 v[36:39], v75 offset:1280
    ds_read_b128 v[32:35], v75 offset:1040
    ds_read_b128 v[40:43], v75 offset:1296
    s_waitcnt lgkmcnt(0)
    v_pk_fma_f32 v[12:13], v[12:13], v[28:29], v[36:37]
    v_pk_fma_f32 v[14:15], v[14:15], v[30:31], v[38:39]
    v_pk_fma_f32 v[16:17], v[16:17], v[32:33], v[40:41]
    v_pk_fma_f32 v[18:19], v[18:19], v[34:35], v[42:43]
    v_pk_fma_f32 v[20:21], v[20:21], v[28:29], v[36:37]
    v_pk_fma_f32 v[22:23], v[22:23], v[30:31], v[38:39]
    v_pk_fma_f32 v[24:25], v[24:25], v[32:33], v[40:41]
    v_pk_fma_f32 v[26:27], v[26:27], v[34:35], v[42:43]
    v_pk_mul_f32 v[44:45], v[12:13], v[12:13]
    v_pk_mul_f32 v[46:47], v[14:15], v[14:15]
    v_pk_mul_f32 v[48:49], v[16:17], v[16:17]
    v_pk_mul_f32 v[50:51], v[18:19], v[18:19]
    v_pk_mul_f32 v[52:53], v[20:21], v[20:21]
    v_pk_mul_f32 v[54:55], v[22:23], v[22:23]
    v_pk_mul_f32 v[56:57], v[24:25], v[24:25]
    v_pk_mul_f32 v[58:59], v[26:27], v[26:27]
    v_pk_fma_f32 v[44:45], v[44:45], v[82:83], v[80:81] op_sel_hi:[1,0,0]
    v_pk_fma_f32 v[46:47], v[46:47], v[82:83], v[80:81] op_sel_hi:[1,0,0]
    v_pk_fma_f32 v[48:49], v[48:49], v[82:83], v[80:81] op_sel_hi:[1,0,0]
    v_pk_fma_f32 v[50:51], v[50:51], v[82:83], v[80:81] op_sel_hi:[1,0,0]
    v_pk_fma_f32 v[52:53], v[52:53], v[82:83], v[80:81] op_sel_hi:[1,0,0]
    v_pk_fma_f32 v[54:55], v[54:55], v[82:83], v[80:81] op_sel_hi:[1,0,0]
    v_pk_fma_f32 v[56:57], v[56:57], v[82:83], v[80:81] op_sel_hi:[1,0,0]
    v_pk_fma_f32 v[58:59], v[58:59], v[82:83], v[80:81] op_sel_hi:[1,0,0]
    v_pk_mul_f32 v[44:45], v[44:45], v[12:13]
    v_pk_mul_f32 v[46:47], v[46:47], v[14:15]
    v_pk_mul_f32 v[48:49], v[48:49], v[16:17]
    v_pk_mul_f32 v[50:51], v[50:51], v[18:19]
    v_pk_mul_f32 v[52:53], v[52:53], v[20:21]
    v_pk_mul_f32 v[54:55], v[54:55], v[22:23]
    v_pk_mul_f32 v[56:57], v[56:57], v[24:25]
    v_pk_mul_f32 v[58:59], v[58:59], v[26:27]
    v_exp_f32 v44, v44
    v_exp_f32 v45, v45
    v_exp_f32 v46, v46
    v_exp_f32 v47, v47
    v_exp_f32 v48, v48
    v_exp_f32 v49, v49
    v_exp_f32 v50, v50
    v_exp_f32 v51, v51
    v_exp_f32 v52, v52
    v_exp_f32 v53, v53
    v_exp_f32 v54, v54
    v_exp_f32 v55, v55
    v_exp_f32 v56, v56
    v_exp_f32 v57, v57
    v_exp_f32 v58, v58
    v_exp_f32 v59, v59
    v_pk_add_f32 v[44:45], v[44:45], v[84:85] op_sel_hi:[1,0]
    v_pk_add_f32 v[46:47], v[46:47], v[84:85] op_sel_hi:[1,0]
    v_pk_add_f32 v[48:49], v[48:49], v[84:85] op_sel_hi:[1,0]
    v_pk_add_f32 v[50:51], v[50:51], v[84:85] op_sel_hi:[1,0]
    v_pk_add_f32 v[52:53], v[52:53], v[84:85] op_sel_hi:[1,0]
    v_pk_add_f32 v[54:55], v[54:55], v[84:85] op_sel_hi:[1,0]
    v_pk_add_f32 v[56:57], v[56:57], v[84:85] op_sel_hi:[1,0]
    v_pk_add_f32 v[58:59], v[58:59], v[84:85] op_sel_hi:[1,0]
    v_rcp_f32 v44, v44
    v_rcp_f32 v45, v45
    v_rcp_f32 v46, v46
    v_rcp_f32 v47, v47
    v_rcp_f32 v48, v48
    v_rcp_f32 v49, v49
    v_rcp_f32 v50, v50
    v_rcp_f32 v51, v51
    v_rcp_f32 v52, v52
    v_rcp_f32 v53, v53
    v_rcp_f32 v54, v54
    v_rcp_f32 v55, v55
    v_rcp_f32 v56, v56
    v_rcp_f32 v57, v57
    v_rcp_f32 v58, v58
    v_rcp_f32 v59, v59
    v_pk_mul_f32 v[12:13], v[12:13], v[44:45]
    v_pk_mul_f32 v[14:15], v[14:15], v[46:47]
    v_pk_mul_f32 v[16:17], v[16:17], v[48:49]
    v_pk_mul_f32 v[18:19], v[18:19], v[50:51]
    v_pk_mul_f32 v[20:21], v[20:21], v[52:53]
    v_pk_mul_f32 v[22:23], v[22:23], v[54:55]
    v_pk_mul_f32 v[24:25], v[24:25], v[56:57]
    v_pk_mul_f32 v[26:27], v[26:27], v[58:59]
    v_cvt_pk_bf16_f32 v44, v12, v13
    v_cvt_pk_bf16_f32 v45, v14, v15
    v_cvt_pk_bf16_f32 v46, v16, v17
    v_cvt_pk_bf16_f32 v47, v18, v19
    v_cvt_pk_bf16_f32 v48, v20, v21
    v_cvt_pk_bf16_f32 v49, v22, v23
    v_cvt_pk_bf16_f32 v50, v24, v25
    v_cvt_pk_bf16_f32 v51, v26, v27
    buffer_store_dwordx4 v[44:47], v114, s[36:39], 0 offen sc1
    buffer_store_dwordx4 v[48:51], v115, s[36:39], 0 offen sc1
L_end:
    s_endpgm
L_helper:
    v_xor_b32 v12, 64, v8
    s_mov_b32 m0, 103488
    s_add_u32 s57, s61, 4194304
    buffer_load_dwordx4 v8, s[24:27], s57 offen lds
    s_mov_b32 m0, 104512
    s_add_u32 s57, s61, 4202496
    buffer_load_dwordx4 v12, s[24:27], s57 offen lds
    s_mov_b32 m0, 105536
    s_add_u32 s57, s61, 4210688
    buffer_load_dwordx4 v8, s[24:27], s57 offen lds
    s_mov_b32 m0, 106560
    s_add_u32 s57, s61, 4218880
    buffer_load_dwordx4 v12, s[24:27], s57 offen lds
    s_mov_b32 m0, 107584
    s_add_u32 s57, s61, 4227072
    buffer_load_dwordx4 v8, s[24:27], s57 offen lds
    s_mov_b32 m0, 108608
    s_add_u32 s57, s61, 4235264
    buffer_load_dwordx4 v12, s[24:27], s57 offen lds
    s_mov_b32 m0, 109632
    s_add_u32 s57, s61, 4243456
    buffer_load_dwordx4 v8, s[24:27], s57 offen lds
    s_mov_b32 m0, 110656
    s_add_u32 s57, s61, 4251648
    buffer_load_dwordx4 v12, s[24:27], s57 offen lds
    s_mov_b32 m0, 111680
    s_add_u32 s57, s61, 5242880
    buffer_load_dwordx4 v8, s[24:27], s57 offen lds
    s_mov_b32 m0, 112704
    s_add_u32 s57, s61, 5251072
    buffer_load_dwordx4 v12, s[24:27], s57 offen lds
    s_mov_b32 m0, 113728
    s_add_u32 s57, s61, 5259264
    buffer_load_dwordx4 v8, s[24:27], s57 offen lds
    s_mov_b32 m0, 114752
    s_add_u32 s57, s61, 5267456
    buffer_load_dwordx4 v12, s[24:27], s57 offen lds
    s_mov_b32 m0, 115776
    s_add_u32 s57, s61, 5275648
    buffer_load_dwordx4 v8, s[24:27], s57 offen lds
    s_mov_b32 m0, 116800
    s_add_u32 s57, s61, 5283840
    buffer_load_dwordx4 v12, s[24:27], s57 offen lds
    s_mov_b32 m0, 117824
    s_add_u32 s57, s61, 5292032
    buffer_load_dwordx4 v8, s[24:27], s57 offen lds
    s_mov_b32 m0, 118848
    s_add_u32 s57, s61, 5300224
    buffer_load_dwordx4 v12, s[24:27], s57 offen lds
    s_mov_b32 s28, s18
    s_and_b32 s29, s19, 0xffff
    s_mov_b32 s30, 268435456
    s_mov_b32 s31, 0x00020000
    s_mov_b32 s40, s16
    s_and_b32 s41, s17, 0xffff
    s_mov_b32 s42, 256
    s_mov_b32 s43, 0x00020000
    s_mov_b32 s32, s4
    s_and_b32 s33, s5, 0xffff
    s_mov_b32 s34, 8192000
    s_mov_b32 s35, 0x00020000
    s_lshl_b32 s71, s46, 3
    s_add_u32 s71, s71, s47
    s_lshl_b32 s57, s71, 13
    s_lshl_b32 s58, s48, 9
    s_add_u32 s58, s58, s57
    v_lshl_add_u32 v2, v1, 3, s58
    v_mov_b32 v14, 0
    v_mov_b32 v15, -1.0
    buffer_store_dwordx2 v[14:15], v2, s[28:31], 0 offen sc1
    v_mov_b32 v4, 0x7f000000
    v_lshlrev_b32 v3, 10, v1
    v_add_u32 v3, 384, v3
    s_mul_i32 s59, s2, 32768
    s_mul_i32 s60, s2, 30720
    v_cmp_gt_u32 vcc, 32, v1
    v_cmp_gt_u32 s[72:73], 30, v1
    s_lshl_b32 s58, s71, 2
    v_mov_b32 v18, s58
    v_cndmask_b32 v16, v4, v3, vcc
    v_cndmask_b32 v17, v4, v3, s[72:73]
    v_mov_b32 v19, 1
    buffer_load_dword v20, v17, s[24:27], s60 offen
    buffer_load_dword v21, v16, s[32:35], s59 offen
    s_mov_b32 m0, 119872
    s_add_u32 s57, s61, 6291456
    buffer_load_dwordx4 v8, s[24:27], s57 offen lds
    s_mov_b32 m0, 120896
    s_add_u32 s57, s61, 6299648
    buffer_load_dwordx4 v12, s[24:27], s57 offen lds
    s_mov_b32 m0, 121920
    s_add_u32 s57, s61, 6307840
    buffer_load_dwordx4 v8, s[24:27], s57 offen lds
    s_mov_b32 m0, 122944
    s_add_u32 s57, s61, 6316032
    buffer_load_dwordx4 v12, s[24:27], s57 offen lds
    s_mov_b32 m0, 123968
    s_add_u32 s57, s61, 6324224
    buffer_load_dwordx4 v8, s[24:27], s57 offen lds
    s_mov_b32 m0, 124992
    s_add_u32 s57, s61, 6332416
    buffer_load_dwordx4 v12, s[24:27], s57 offen lds
    s_mov_b32 m0, 126016
    s_add_u32 s57, s61, 6340608
    buffer_load_dwordx4 v8, s[24:27], s57 offen lds
    s_mov_b32 m0, 127040
    s_add_u32 s57, s61, 6348800
    buffer_load_dwordx4 v12, s[24:27], s57 offen lds
    s_barrier
    s_mov_b32 m0, 128064
    s_add_u32 s57, s61, 7340032
    buffer_load_dwordx4 v8, s[24:27], s57 offen lds
    s_mov_b32 m0, 129088
    s_add_u32 s57, s61, 7348224
    buffer_load_dwordx4 v12, s[24:27], s57 offen lds
    s_mov_b32 m0, 130112
    s_add_u32 s57, s61, 7356416
    buffer_load_dwordx4 v8, s[24:27], s57 offen lds
    s_mov_b32 m0, 131136
    s_add_u32 s57, s61, 7364608
    buffer_load_dwordx4 v12, s[24:27], s57 offen lds
    s_mov_b32 m0, 132160
    s_add_u32 s57, s61, 7372800
    buffer_load_dwordx4 v8, s[24:27], s57 offen lds
    s_mov_b32 m0, 133184
    s_add_u32 s57, s61, 7380992
    buffer_load_dwordx4 v12, s[24:27], s57 offen lds
    s_mov_b32 m0, 134208
    s_add_u32 s57, s61, 7389184
    buffer_load_dwordx4 v8, s[24:27], s57 offen lds
    s_mov_b32 m0, 135232
    s_add_u32 s57, s61, 7397376
    buffer_load_dwordx4 v12, s[24:27], s57 offen lds
    s_mov_b32 m0, 136256
    s_add_u32 s57, s61, 524288
    buffer_load_dwordx4 v8, s[24:27], s57 offen lds
    s_mov_b32 m0, 137280
    s_add_u32 s57, s61, 532480
    buffer_load_dwordx4 v12, s[24:27], s57 offen lds
    s_mov_b32 m0, 138304
    s_add_u32 s57, s61, 540672
    buffer_load_dwordx4 v8, s[24:27], s57 offen lds
    s_mov_b32 m0, 139328
    s_add_u32 s57, s61, 548864
    buffer_load_dwordx4 v12, s[24:27], s57 offen lds
    s_mov_b32 m0, 140352
    s_add_u32 s57, s61, 557056
    buffer_load_dwordx4 v8, s[24:27], s57 offen lds
    s_mov_b32 m0, 141376
    s_add_u32 s57, s61, 565248
    buffer_load_dwordx4 v12, s[24:27], s57 offen lds
    s_mov_b32 m0, 142400
    s_add_u32 s57, s61, 573440
    buffer_load_dwordx4 v8, s[24:27], s57 offen lds
    s_mov_b32 m0, 143424
    s_add_u32 s57, s61, 581632
    buffer_load_dwordx4 v12, s[24:27], s57 offen lds
    s_waitcnt vmcnt(27)
    s_barrier
    s_mov_b32 m0, 144448
    s_add_u32 s57, s61, 1572864
    buffer_load_dwordx4 v8, s[24:27], s57 offen lds
    s_mov_b32 m0, 145472
    s_add_u32 s57, s61, 1581056
    buffer_load_dwordx4 v12, s[24:27], s57 offen lds
    s_mov_b32 m0, 146496
    s_add_u32 s57, s61, 1589248
    buffer_load_dwordx4 v8, s[24:27], s57 offen lds
    s_mov_b32 m0, 147520
    s_add_u32 s57, s61, 1597440
    buffer_load_dwordx4 v12, s[24:27], s57 offen lds
    s_mov_b32 m0, 148544
    s_add_u32 s57, s61, 1605632
    buffer_load_dwordx4 v8, s[24:27], s57 offen lds
    s_mov_b32 m0, 149568
    s_add_u32 s57, s61, 1613824
    buffer_load_dwordx4 v12, s[24:27], s57 offen lds
    s_mov_b32 m0, 150592
    s_add_u32 s57, s61, 1622016
    buffer_load_dwordx4 v8, s[24:27], s57 offen lds
    s_mov_b32 m0, 151616
    s_add_u32 s57, s61, 1630208
    buffer_load_dwordx4 v12, s[24:27], s57 offen lds
    s_mov_b32 m0, 35360
    s_add_u32 s57, s66, 0
    buffer_load_dwordx4 v9, s[20:23], s57 offen lds
    s_mov_b32 m0, 36400
    s_add_u32 s57, s66, 8192
    buffer_load_dwordx4 v9, s[20:23], s57 offen lds
    s_mov_b32 m0, 37440
    s_add_u32 s57, s66, 16384
    buffer_load_dwordx4 v9, s[20:23], s57 offen lds
    s_mov_b32 m0, 38480
    s_add_u32 s57, s66, 24576
    buffer_load_dwordx4 v9, s[20:23], s57 offen lds
    s_mov_b32 m0, 39520
    s_add_u32 s57, s66, 32768
    buffer_load_dwordx4 v9, s[20:23], s57 offen lds
    s_mov_b32 m0, 40560
    s_add_u32 s57, s66, 40960
    buffer_load_dwordx4 v9, s[20:23], s57 offen lds
    s_mov_b32 m0, 41600
    s_add_u32 s57, s66, 49152
    buffer_load_dwordx4 v9, s[20:23], s57 offen lds
    s_mov_b32 m0, 42640
    s_add_u32 s57, s66, 57344
    buffer_load_dwordx4 v9, s[20:23], s57 offen lds
    s_mov_b32 m0, 43680
    s_add_u32 s57, s66, 65536
    buffer_load_dwordx4 v9, s[20:23], s57 offen lds
    s_waitcnt vmcnt(25)
    s_barrier
    s_mov_b32 m0, 44720
    s_add_u32 s57, s66, 73728
    buffer_load_dwordx4 v9, s[20:23], s57 offen lds
    s_mov_b32 m0, 45760
    s_add_u32 s57, s66, 81920
    buffer_load_dwordx4 v9, s[20:23], s57 offen lds
    s_mov_b32 m0, 46800
    s_add_u32 s57, s66, 90112
    buffer_load_dwordx4 v9, s[20:23], s57 offen lds
    s_mov_b32 m0, 47840
    s_add_u32 s57, s66, 98304
    buffer_load_dwordx4 v9, s[20:23], s57 offen lds
    s_mov_b32 m0, 48880
    s_add_u32 s57, s66, 106496
    buffer_load_dwordx4 v9, s[20:23], s57 offen lds
    s_mov_b32 m0, 49920
    s_add_u32 s57, s66, 114688
    buffer_load_dwordx4 v9, s[20:23], s57 offen lds
    s_mov_b32 m0, 50960
    s_add_u32 s57, s66, 122880
    buffer_load_dwordx4 v9, s[20:23], s57 offen lds
    s_mov_b32 m0, 52000
    s_add_u32 s57, s66, 131072
    buffer_load_dwordx4 v9, s[20:23], s57 offen lds
    s_mov_b32 m0, 53040
    s_add_u32 s57, s66, 139264
    buffer_load_dwordx4 v9, s[20:23], s57 offen lds
    s_mov_b32 m0, 54080
    s_add_u32 s57, s66, 147456
    buffer_load_dwordx4 v9, s[20:23], s57 offen lds
    s_mov_b32 m0, 55120
    s_add_u32 s57, s66, 155648
    buffer_load_dwordx4 v9, s[20:23], s57 offen lds
    s_mov_b32 m0, 56160
    s_add_u32 s57, s66, 163840
    buffer_load_dwordx4 v9, s[20:23], s57 offen lds
    s_mov_b32 m0, 57200
    s_add_u32 s57, s66, 172032
    buffer_load_dwordx4 v9, s[20:23], s57 offen lds
    s_mov_b32 m0, 58240
    s_add_u32 s57, s66, 180224
    buffer_load_dwordx4 v9, s[20:23], s57 offen lds
    s_mov_b32 m0, 59280
    s_add_u32 s57, s66, 188416
    buffer_load_dwordx4 v9, s[20:23], s57 offen lds
    s_mov_b32 m0, 60320
    s_add_u32 s57, s66, 196608
    buffer_load_dwordx4 v9, s[20:23], s57 offen lds
    s_mov_b32 m0, 61360
    s_add_u32 s57, s66, 204800
    buffer_load_dwordx4 v9, s[20:23], s57 offen lds
    s_waitcnt vmcnt(26)
    s_barrier
    s_mov_b32 m0, 62400
    s_add_u32 s57, s66, 212992
    buffer_load_dwordx4 v9, s[20:23], s57 offen lds
    s_mov_b32 m0, 63440
    s_add_u32 s57, s66, 221184
    buffer_load_dwordx4 v9, s[20:23], s57 offen lds
    s_mov_b32 m0, 64480
    s_add_u32 s57, s66, 229376
    buffer_load_dwordx4 v9, s[20:23], s57 offen lds
    s_mov_b32 m0, 65520
    s_add_u32 s57, s66, 237568
    buffer_load_dwordx4 v9, s[20:23], s57 offen lds
    s_mov_b32 m0, 66560
    s_add_u32 s57, s66, 245760
    buffer_load_dwordx4 v9, s[20:23], s57 offen lds
    s_mov_b32 m0, 67600
    s_add_u32 s57, s66, 253952
    buffer_load_dwordx4 v9, s[20:23], s57 offen lds
    s_mov_b32 m0, 68640
    s_add_u32 s57, s66, 262144
    buffer_load_dwordx4 v9, s[20:23], s57 offen lds
    s_mov_b32 m0, 69680
    s_add_u32 s57, s66, 270336
    buffer_load_dwordx4 v9, s[20:23], s57 offen lds
    s_barrier
    v_cmp_eq_u32 vcc, 0, v1
    s_nop 1
    s_and_saveexec_b64 s[74:75], vcc
    buffer_atomic_add v19, v18, s[40:43], 0 offen offset:0 sc1
    s_mov_b64 exec, s[74:75]
    s_waitcnt vmcnt(1)
    s_barrier
    s_barrier
    s_mov_b32 s57, 0
L_hloop:
    s_barrier
    s_add_u32 s57, s57, 1
    s_cmp_lt_u32 s57, 16
    s_cbranch_scc1 L_hloop
    s_waitcnt vmcnt(0)
    s_endpgm
.section .rodata,"a"
.p2align 6
.amdhsa_kernel standalone__self_sup_conv_stem_hubert__speech_kernel
  .amdhsa_next_free_vgpr 168
  .amdhsa_next_free_sgpr 102
  .amdhsa_accum_offset 168
  .amdhsa_group_segment_fixed_size 0
  .amdhsa_kernarg_size 64
  .amdhsa_user_sgpr_count 2
  .amdhsa_user_sgpr_kernarg_segment_ptr 1
  .amdhsa_system_sgpr_workgroup_id_x 1
  .amdhsa_float_denorm_mode_32 3
.end_amdhsa_kernel
```
